```python
import torch

def _softmax(x, axis=-1):
    return torch.softmax(x, dim=axis)
def _gelu(x):
    return torch.nn.functional.gelu(x, approximate="tanh")
def _silu(x):
    return torch.nn.functional.silu(x)
def _sigmoid(x):
    return torch.sigmoid(x)
def _layernorm(x, axis=-1, eps=1e-5):
    m = x.mean(dim=axis, keepdim=True)
    v = x.var(dim=axis, keepdim=True, unbiased=False)
    return (x - m) / torch.sqrt(v + eps)
def _scatter_add(tgt, idx, src, axis=0):
    return tgt.clone().index_add_(axis, idx, src)
def _segment_sum(src, seg, n):
    out = torch.zeros((n,) + src.shape[1:], dtype=src.dtype)
    return out.index_add_(0, seg, src)
def _pad(x, pw):
    flat = tuple(v for pair in reversed(pw) for v in pair)
    return torch.nn.functional.pad(x, flat)

kernel_name = 'standalone__paged_block_table_kv_pagedattention__decode'

def setup_inputs():

    _w = (lambda a: (lambda t: t.to(torch.bfloat16) if t.is_floating_point() else t)(torch.as_tensor(a)))
    B, Hq, Hkv, Sq, Skv, D = 1, 32, 8, 1, 65536, 128
    bs = 16
    nbps = max(1, Skv // bs)
    num_phys = B * nbps + 4
    bt = torch.randperm(num_phys)[: B * nbps].reshape(B, nbps).to(torch.int64)
    cl = (nbps * bs - (torch.arange(1, B + 1, dtype=torch.int64) * 2654435761) % max(1, nbps * bs // 2)).to(torch.int64)
    return {
        "q": _w((lambda *s: torch.randn(*s, dtype=torch.bfloat16) * 0.8)(B, Hq, Sq, D)),
        "k_cache": _w((lambda *s: torch.randn(*s, dtype=torch.bfloat16) * 0.8)(num_phys, bs, Hkv, D)),
        "v_cache": _w((lambda *s: torch.randn(*s, dtype=torch.bfloat16) * 0.05)(num_phys, bs, Hkv, D)),
        "block_table": _w(bt),
        "context_lens": _w(cl),
    }

def reference(q, k_cache, v_cache, block_table, context_lens):
    B, Hq, Sq, D = q.shape
    bs = k_cache.shape[1]
    Hkv = k_cache.shape[2]
    nbps = block_table.shape[1]
    Skv = nbps * bs
    bt = block_table.reshape(-1)
    k = (lambda x, *d: x.permute(*d))(k_cache[bt].reshape(B, Skv, Hkv, D), 0, 2, 1, 3)
    v = (lambda x, *d: x.permute(*d))(v_cache[bt].reshape(B, Skv, Hkv, D), 0, 2, 1, 3)
    g = Hq // Hkv
    qg = q.reshape(B, Hkv, g, Sq, D)
    scores = torch.einsum("bhgqd,bhkd->bhgqk", qg, k) * (D ** -0.5)
    pos = torch.arange(Skv)
    msk = pos[None, :] < context_lens[:, None]
    scores = torch.where(msk[:, None, None, None, :], scores, -1e9)
    p = _softmax(scores, axis=-1)
    out = torch.einsum("bhgqk,bhkd->bhgqd", p, v)
    return out.reshape(B, Hq, Sq, D)
```

```asm
; @launch grid=(256,1,1) block=(320,1,1) lds=10240
.amdgcn_target "amdgcn-amd-amdhsa--gfx950"
.text
.globl standalone__paged_block_table_kv_pagedattention__decode_kernel
.p2align 8
.type standalone__paged_block_table_kv_pagedattention__decode_kernel,@function
standalone__paged_block_table_kv_pagedattention__decode_kernel:
  s_load_dwordx16 s[4:19], s[0:1], 0
  s_cmp_ge_u32 s2, 256
  s_cbranch_scc1 L_end
  v_lshrrev_b32 v11, 6, v0
  v_and_b32 v1, 63, v0
  v_readfirstlane_b32 s42, v11
  s_lshr_b32 s72, s2, 3
  s_and_b32 s40, s2, 7
  s_cmp_ge_u32 s42, 4
  s_cbranch_scc1 L_service
  s_lshl2_add_u32 s43, s72, s42
  s_lshl_b32 s55, s43, 2
  s_mov_b64 s[68:69], 0
  s_lshl_b32 s41, s42, 2
L_setup:
  v_lshrrev_b32 v7, 4, v1
  v_lshlrev_b32 v7, 2, v7
  v_and_b32 v11, 3, v1
  v_add_lshl_u32 v11, v11, v7, 4
  v_bfe_u32 v10, v1, 2, 2
  s_lshl_b32 s53, s40, 8
  v_lshl_add_u32 v2, v10, 13, v11
  v_add_u32 v2, s53, v2
  v_add_u32 v3, 0x1000, v2
  v_lshl_add_u32 v12, v10, 8, v11
  v_and_b32 v11, 15, v1
  v_lshlrev_b32 v11, 4, v11
  v_lshl_add_u32 v4, v7, 11, v11
  v_add_u32 v4, s53, v4
  v_lshl_add_u32 v12, s40, 10, v12
  s_mov_b32 s22, 134348800
  s_mov_b32 s23, 0x20000
  s_mov_b64 s[26:27], s[22:23]
  s_waitcnt lgkmcnt(0)
  s_load_dword s56, s[10:11], s55
  global_load_dwordx4 v[16:19], v12, s[4:5]
  s_mov_b64 s[20:21], s[6:7]
  s_mov_b64 s[24:25], s[8:9]
  s_waitcnt lgkmcnt(0)
  s_lshl_b32 s48, s56, 15
  buffer_load_dwordx4 v[88:91], v2, s[20:23], s48 offen nt
  buffer_load_dwordx4 v[92:95], v2, s[20:23], s48 offen offset:2048 nt
  buffer_load_dwordx4 v[96:99], v3, s[20:23], s48 offen nt
  buffer_load_dwordx4 v[100:103], v3, s[20:23], s48 offen offset:2048 nt
  buffer_load_dwordx4 v[104:107], v4, s[24:27], s48 offen nt
  buffer_load_dwordx4 v[108:111], v4, s[24:27], s48 offen offset:2048 nt
  v_add_u32 v5, 0x1000, v4
  v_mov_b32 v6, s41
  s_mov_b64 s[36:37], s[18:19]
  s_mov_b32 s38, 294912
  s_mov_b32 s39, 0x20000
  v_lshlrev_b32 v120, 4, v1
  s_cmp_lg_u32 s68, 0
  s_cbranch_scc1 L_loop
  s_mov_b32 s49, 0x3e0293ee
  s_mov_b32 s50, 0x05040100
  s_mov_b32 s51, 0x07060302
  s_mov_b32 s54, 0xceabfb8f
  v_mov_b32 v8, 0xff61b1e6
  v_mov_b32 v9, 0
  v_mov_b32 v124, 1024
  v_mov_b32 v126, 4
  s_lshr_b32 s85, s69, 31
  s_mov_b32 s83, 0
  s_mov_b32 s80, 0x11111111
  s_mov_b32 s81, s80
  s_bitset1_b32 s85, 31
  v_mov_b32 v56, 0
  v_mov_b32 v60, 0
  v_mov_b32 v64, 0
  v_mov_b32 v68, 0
  v_mov_b32 v72, 0
  v_mov_b32 v76, 0
  v_mov_b32 v80, 0
  v_mov_b32 v84, 0
  s_cmp_lg_u32 s69, 0
  s_cbranch_scc1 L_loop
  s_barrier
  s_lshl_b32 s52, s42, 3
  v_lshl_add_u32 v170, v10, 5, s52
  v_lshl_add_u32 v162, v7, 3, s52
  v_xor_b32 v163, 8, v162
  v_xor_b32 v164, 16, v162
  v_xor_b32 v165, 24, v162
  s_lshl_b32 s52, s42, 11
  v_add_u32 v169, s52, v120
  v_xor_b32 v166, 0x800, v169
  v_xor_b32 v167, 0x1000, v169
  v_xor_b32 v168, 0x1800, v169
  s_lshl_b32 s57, s40, 5
  s_add_u32 s57, s57, s72
  s_lshl_b32 s57, s57, 10
L_loop:
  s_mov_b64 exec, 1
  ds_add_rtn_u32 v125, v124, v126
  s_mov_b64 exec, -1
  s_waitcnt vmcnt(5)
  v_mfma_f32_16x16x32_bf16 v[24:27], v[88:91], v[16:19], 0
  buffer_load_dwordx4 v[112:115], v5, s[24:27], s48 offen nt
  s_waitcnt vmcnt(5)
  v_mfma_f32_16x16x32_bf16 v[28:31], v[92:95], v[16:19], 0
  buffer_load_dwordx4 v[116:119], v5, s[24:27], s48 offen offset:2048 nt
  s_waitcnt lgkmcnt(0)
L_get:
  s_mov_b64 exec, 1
  ds_read_b32 v122, v6
  ds_read_b32 v123, v125
  s_mov_b64 exec, -1
  s_waitcnt vmcnt(5)
  v_mfma_f32_16x16x32_bf16 v[32:35], v[96:99], v[16:19], 0
  s_waitcnt lgkmcnt(0)
  v_readfirstlane_b32 s52, v123
  v_readfirstlane_b32 s47, v122
  s_max_u32 s53, s52, s47
  s_cmp_eq_u32 s53, -1
  s_cbranch_scc1 L_retry
  s_and_b32 s59, s52, 0xffff8000
  s_and_b32 s47, s47, 31
  s_and_b32 s77, s52, 32
  v_mov_b32 v6, v125
  buffer_load_dwordx4 v[88:91], v2, s[20:23], s59 offen nt
  s_waitcnt vmcnt(5)
  v_mfma_f32_16x16x32_bf16 v[36:39], v[100:103], v[16:19], 0
  buffer_load_dwordx4 v[92:95], v2, s[20:23], s59 offen offset:2048 nt
  v_add_f32_dpp v20, v25, v24 quad_perm:[1,1,1,1] row_mask:0xf bank_mask:0xf
  v_add_f32_dpp v21, v29, v28 quad_perm:[1,1,1,1] row_mask:0xf bank_mask:0xf
  v_add_f32_dpp v22, v33, v32 quad_perm:[1,1,1,1] row_mask:0xf bank_mask:0xf
  s_nop 3
  v_add_f32_dpp v23, v37, v36 quad_perm:[1,1,1,1] row_mask:0xf bank_mask:0xf
  v_add_f32_dpp v20, v26, v20 quad_perm:[2,2,2,2] row_mask:0xf bank_mask:0xf
  v_add_f32_dpp v21, v30, v21 quad_perm:[2,2,2,2] row_mask:0xf bank_mask:0xf
  v_add_f32_dpp v22, v34, v22 quad_perm:[2,2,2,2] row_mask:0xf bank_mask:0xf
  v_add_f32_dpp v23, v38, v23 quad_perm:[2,2,2,2] row_mask:0xf bank_mask:0xf
  v_add_f32_dpp v20, v27, v20 quad_perm:[3,3,3,3] row_mask:0xf bank_mask:0xf
  v_add_f32_dpp v21, v31, v21 quad_perm:[3,3,3,3] row_mask:0xf bank_mask:0xf
  v_add_f32_dpp v22, v35, v22 quad_perm:[3,3,3,3] row_mask:0xf bank_mask:0xf
  v_add_f32_dpp v23, v39, v23 quad_perm:[3,3,3,3] row_mask:0xf bank_mask:0xf
  v_mul_f32 v20, s49, v20
  v_mul_f32 v21, s49, v21
  v_mul_f32 v22, s49, v22
  v_mul_f32 v23, s49, v23
  s_cmp_lt_u32 s47, 16
  s_cbranch_scc1 L_mask
L_nomask:
  v_max3_f32 v10, v20, v21, v22
  v_max_f32 v10, v10, v23
  v_cmp_gt_f32 vcc, v10, v8
  s_and_b64 vcc, vcc, s[80:81]
  s_cbranch_scc1 L_newmax
L_maxok:
  s_waitcnt vmcnt(5)
  buffer_load_dwordx4 v[96:99], v3, s[20:23], s59 offen nt
  v_sub_f32 v20, v20, v8
  v_sub_f32 v21, v21, v8
  v_exp_f32 v20, v20
  v_sub_f32 v22, v22, v8
  v_exp_f32 v21, v21
  v_sub_f32 v23, v23, v8
  v_exp_f32 v22, v22
  v_add_f32 v9, v9, v20
  v_exp_f32 v23, v23
  v_add_f32 v11, v21, v22
  v_cvt_pk_bf16_f32 v14, v20, v21
  v_add_f32 v9, v9, v23
  s_cmp_eq_u32 s59, s85
  v_cvt_pk_bf16_f32 v15, v22, v23
  v_add_f32 v9, v9, v11
  s_cbranch_scc1 L_none
L_mld:
  s_waitcnt vmcnt(5)
  buffer_load_dwordx4 v[100:103], v3, s[20:23], s59 offen offset:2048 nt
  v_perm_b32 v40, v108, v104, s50
  v_perm_b32 v42, v108, v104, s51
  v_perm_b32 v44, v109, v105, s50
  v_perm_b32 v46, v109, v105, s51
  v_perm_b32 v48, v110, v106, s50
  v_perm_b32 v50, v110, v106, s51
  v_perm_b32 v52, v111, v107, s50
  v_perm_b32 v54, v111, v107, s51
  s_cmp_eq_u32 s59, s85
  s_cbranch_scc0 L_nolast
  s_waitcnt lgkmcnt(0)
  v_readfirstlane_b32 s83, v125
L_nolast:
  s_waitcnt vmcnt(5)
  buffer_load_dwordx4 v[104:107], v4, s[24:27], s59 offen nt
  s_cmp_eq_u32 s83, 12
  s_cbranch_scc0 L_nopre
  ds_read_b32 v152, v124 offset:64
  ds_read_b32 v12, v124 offset:72
  ds_read_b32 v154, v162 offset:1152
  ds_read_b32 v156, v163 offset:1152
  ds_read_b32 v158, v164 offset:1152
  ds_read_b32 v160, v165 offset:1152
  ds_read_b128 v[128:131], v166 offset:2048
  ds_read_b128 v[132:135], v166 offset:3072
  ds_read_b128 v[136:139], v167 offset:2048
  ds_read_b128 v[140:143], v167 offset:3072
  ds_read_b128 v[144:147], v168 offset:2048
  ds_read_b128 v[148:151], v168 offset:3072
L_nopre:
  s_waitcnt vmcnt(5)
  buffer_load_dwordx4 v[108:111], v4, s[24:27], s59 offen offset:2048 nt
  v_perm_b32 v41, v116, v112, s50
  v_perm_b32 v43, v116, v112, s51
  v_perm_b32 v45, v117, v113, s50
  v_mfma_f32_16x16x16_bf16 v[56:59], v[14:15], v[40:41], v[56:59]
  v_perm_b32 v47, v117, v113, s51
  v_mfma_f32_16x16x16_bf16 v[60:63], v[14:15], v[42:43], v[60:63]
  v_perm_b32 v49, v118, v114, s50
  v_mfma_f32_16x16x16_bf16 v[64:67], v[14:15], v[44:45], v[64:67]
  v_perm_b32 v51, v118, v114, s51
  v_mfma_f32_16x16x16_bf16 v[68:71], v[14:15], v[46:47], v[68:71]
  v_perm_b32 v53, v119, v115, s50
  v_mfma_f32_16x16x16_bf16 v[72:75], v[14:15], v[48:49], v[72:75]
  v_perm_b32 v55, v119, v115, s51
  v_mfma_f32_16x16x16_bf16 v[76:79], v[14:15], v[50:51], v[76:79]
  v_mfma_f32_16x16x16_bf16 v[80:83], v[14:15], v[52:53], v[80:83]
  v_mfma_f32_16x16x16_bf16 v[84:87], v[14:15], v[54:55], v[84:87]
  s_mov_b32 s48, s59
  s_cmp_eq_u32 s59, 0x80000000
  s_cbranch_scc0 L_loop
  s_cmp_lg_u32 s69, 0
  s_cbranch_scc1 L_fbnext
  s_cmp_eq_u32 s83, 12
  s_cbranch_scc0 L_give
L_mrg:
  s_waitcnt lgkmcnt(6)
  v_readfirstlane_b32 s52, v152
  v_max3_f32 v10, v154, v156, v158
  v_max_f32 v10, v10, v160
  v_sub_f32 v156, v156, v10
  v_sub_f32 v158, v158, v10
  v_sub_f32 v160, v160, v10
  v_sub_f32 v154, v154, v10
  s_cmp_eq_u32 s52, 12
  s_cbranch_scc0 L_again
  v_exp_f32 v156, v156
  v_exp_f32 v158, v158
  v_exp_f32 v160, v160
  v_exp_f32 v154, v154
  s_waitcnt lgkmcnt(4)
  v_pk_mul_f32 v[24:25], v[156:157], v[128:129] op_sel_hi:[0,1]
  v_pk_mul_f32 v[26:27], v[156:157], v[130:131] op_sel_hi:[0,1]
  v_pk_mul_f32 v[28:29], v[156:157], v[132:133] op_sel_hi:[0,1]
  v_pk_mul_f32 v[30:31], v[156:157], v[134:135] op_sel_hi:[0,1]
  s_waitcnt lgkmcnt(2)
  v_pk_fma_f32 v[24:25], v[158:159], v[136:137], v[24:25] op_sel_hi:[0,1,1]
  v_pk_fma_f32 v[26:27], v[158:159], v[138:139], v[26:27] op_sel_hi:[0,1,1]
  v_pk_fma_f32 v[28:29], v[158:159], v[140:141], v[28:29] op_sel_hi:[0,1,1]
  v_pk_fma_f32 v[30:31], v[158:159], v[142:143], v[30:31] op_sel_hi:[0,1,1]
  s_waitcnt lgkmcnt(0)
  v_pk_fma_f32 v[24:25], v[160:161], v[144:145], v[24:25] op_sel_hi:[0,1,1]
  v_pk_fma_f32 v[26:27], v[160:161], v[146:147], v[26:27] op_sel_hi:[0,1,1]
  v_pk_fma_f32 v[28:29], v[160:161], v[148:149], v[28:29] op_sel_hi:[0,1,1]
  v_pk_fma_f32 v[30:31], v[160:161], v[150:151], v[30:31] op_sel_hi:[0,1,1]
  s_cmp_lg_u32 s77, 0
  v_fmac_f32 v24, v154, v56
  v_fmac_f32 v25, v154, v60
  v_fmac_f32 v26, v154, v64
  v_fmac_f32 v27, v154, v68
  v_fmac_f32 v28, v154, v72
  v_fmac_f32 v29, v154, v76
  v_fmac_f32 v30, v154, v80
  v_fmac_f32 v31, v154, v84
  v_cvt_pk_bf16_f32 v24, v24, v25
  v_xor_b32 v24, v12, v24
  v_cvt_pk_bf16_f32 v25, v26, v27
  v_xor_b32 v25, v12, v25
  v_cvt_pk_bf16_f32 v26, v28, v29
  v_xor_b32 v26, v12, v26
  v_cvt_pk_bf16_f32 v27, v30, v31
  v_xor_b32 v27, v12, v27
  s_cbranch_scc1 L_dn1
  buffer_store_dwordx4 v[24:27], v120, s[36:39], s57 offen
  s_endpgm
L_dn1:
  buffer_store_dwordx4 v[24:27], v120, s[36:39], s57 offen sc1
  s_endpgm
L_again:
  s_waitcnt lgkmcnt(0)
  ds_read_b32 v152, v124 offset:64
  ds_read_b32 v12, v124 offset:72
  ds_read_b32 v154, v162 offset:1152
  ds_read_b32 v156, v163 offset:1152
  ds_read_b32 v158, v164 offset:1152
  ds_read_b32 v160, v165 offset:1152
  ds_read_b128 v[128:131], v166 offset:2048
  ds_read_b128 v[132:135], v166 offset:3072
  ds_read_b128 v[136:139], v167 offset:2048
  ds_read_b128 v[140:143], v167 offset:3072
  ds_read_b128 v[144:147], v168 offset:2048
  ds_read_b128 v[148:151], v168 offset:3072
  s_branch L_mrg
L_give:
  v_mov_b32 v24, v56
  v_mov_b32 v25, v60
  v_mov_b32 v26, v64
  v_mov_b32 v27, v68
  v_mov_b32 v28, v72
  v_mov_b32 v29, v76
  v_mov_b32 v30, v80
  v_mov_b32 v31, v84
  ds_write_b128 v169, v[24:27] offset:2048
  ds_write_b128 v169, v[28:31] offset:3072
  s_mov_b64 exec, 1
  ds_add_u32 v124, v126 offset:64
  s_waitcnt lgkmcnt(0)
  s_endpgm
L_retry:
  s_cmp_eq_u32 s47, 0x80000000
  s_cbranch_scc0 L_get
  s_mov_b32 s77, 32
L_none:
  v_mov_b32 v11, v9
  s_nop 1
  v_permlane32_swap_b32 v9, v11
  v_add_f32 v9, v9, v11
  v_mov_b32 v11, v9
  s_nop 1
  v_permlane16_swap_b32 v9, v11
  v_add_f32 v9, v9, v11
  s_mov_b32 exec_lo, 0x1111
  s_mov_b32 exec_hi, 0
  ds_write_b64 v170, v[8:9] offset:1152
  s_mov_b64 exec, 1
  ds_add_rtn_u32 v125, v124, v126 offset:68
  s_mov_b64 exec, -1
  s_cmp_eq_u32 s47, 0x80000000
  s_cbranch_scc0 L_mld
  s_waitcnt lgkmcnt(0)
  v_readfirstlane_b32 s83, v125
  s_cmp_eq_u32 s83, 12
  s_cbranch_scc1 L_again
  s_branch L_give
L_newmax:
  v_max_f32 v10, v10, v8
  v_mov_b32 v11, v10
  s_nop 1
  v_permlane32_swap_b32 v10, v11
  v_max_f32 v10, v10, v11
  v_mov_b32 v11, v10
  s_nop 1
  v_permlane16_swap_b32 v10, v11
  v_max_f32 v10, v10, v11
  v_sub_f32 v12, v8, v10
  v_exp_f32 v12, v12
  v_mov_b32 v8, v10
  v_mul_f32 v9, v9, v12
  v_mov_b32_dpp v13, v12 row_newbcast:0 row_mask:0x1 bank_mask:0xf
  s_nop 1
  v_mov_b32_dpp v13, v12 row_newbcast:4 row_mask:0x2 bank_mask:0xf
  s_nop 1
  v_mov_b32_dpp v13, v12 row_newbcast:8 row_mask:0x4 bank_mask:0xf
  s_nop 1
  v_mov_b32_dpp v13, v12 row_newbcast:12 row_mask:0x8 bank_mask:0xf
  v_mul_f32 v56, v13, v56
  v_mul_f32 v60, v13, v60
  v_mul_f32 v64, v13, v64
  v_mul_f32 v68, v13, v68
  v_mul_f32 v72, v13, v72
  v_mul_f32 v76, v13, v76
  v_mul_f32 v80, v13, v80
  v_mul_f32 v84, v13, v84
  s_branch L_maxok
L_service:
  s_mov_b64 s[68:69], 0
  v_lshlrev_b32 v8, 9, v1
  v_lshlrev_b32 v44, 2, v1
  v_lshlrev_b32 v43, 4, v1
  v_mov_b32 v52, -1
  v_mov_b32 v53, -1
  v_mov_b32 v54, -1
  v_mov_b32 v55, -1
  ds_write_b128 v43, v[52:55]
  v_mov_b32 v9, 0
  s_nop 0
  v_writelane_b32 v9, 16, 0
  ds_write_b32 v44, v9 offset:1024
  s_lshl_b32 s55, s72, 4
  s_lshl_b32 s52, s40, 15
  s_lshl_b32 s53, s72, 5
  s_add_u32 s52, s52, s53
  v_lshrrev_b32 v9, 2, v1
  v_and_b32 v10, 3, v1
  v_lshlrev_b32 v11, 10, v9
  v_lshl_add_u32 v11, v10, 3, v11
  v_add_u32 v2, s52, v11
  v_add_u32 v60, 0x4000, v2
  s_lshr_b32 s46, s72, 3
  s_lshl_b32 s52, s40, 12
  s_lshl4_add_u32 s52, s46, s52
  s_add_u32 s52, s52, 262144
  v_lshlrev_b32 v11, 7, v9
  v_lshl_add_u32 v11, v10, 2, v11
  v_add_u32 v3, s52, v11
  s_lshl_b32 s57, s40, 5
  s_add_u32 s57, s57, s72
  s_lshl_b32 s57, s57, 10
  s_lshr_b32 s58, s57, 3
  s_add_u32 s58, s58, 262144
  s_waitcnt lgkmcnt(0)
  s_load_dword s44, s[12:13], 0
  s_load_dword s70, s[18:19], s57
  s_mov_b64 s[28:29], s[10:11]
  s_mov_b32 s30, 16384
  s_mov_b32 s31, 0x20000
  buffer_load_dwordx4 v[48:51], v8, s[28:31], s55 offen
  s_mov_b64 s[36:37], s[18:19]
  s_mov_b32 s38, 294912
  s_mov_b32 s39, 0x20000
  buffer_load_dword v20, v3, s[36:39], 0 offen sc1
  buffer_load_dword v21, v3, s[36:39], 0 offen offset:2048 sc1
  buffer_load_dwordx2 v[34:35], v2, s[36:39], 0 offen sc1
  buffer_load_dwordx2 v[58:59], v60, s[36:39], 0 offen sc1
  s_lshl_b32 s52, s40, 10
  s_add_u32 s52, s52, s53
  v_lshrrev_b32 v8, 4, v1
  v_lshl_add_u32 v8, v10, 2, v8
  v_lshl_add_u32 v7, v8, 1, s52
  s_barrier
  s_waitcnt lgkmcnt(0)
  s_add_u32 s70, s70, s58
  s_mul_i32 s70, s70, 0x9e3779b1
  s_lshr_b32 s52, s70, 15
  s_xor_b32 s70, s70, s52
  s_mul_i32 s70, s70, 0x85ebca6b
  v_mov_b32 v10, 1024
  v_mov_b32 v9, s70
  ds_write_b32 v10, v9 offset:72
  s_min_i32 s52, s44, 65536
  s_cmp_le_i32 s44, 0
  s_cselect_b32 s52, 65536, s52
  s_add_u32 s52, s52, 15
  s_lshr_b32 s45, s52, 4
  s_min_i32 s44, s44, 65536
  s_max_i32 s44, s44, 0
  s_lshr_b32 s71, s45, 7
  s_max_i32 s71, s71, 1
  s_lshl_b32 s53, s72, 2
  v_lshl_add_u32 v8, v1, 7, s53
  s_lshl_b32 s52, s71, 7
  s_add_u32 s52, s52, s72
  v_lshl_add_u32 v42, v1, 5, s52
  v_lshlrev_b32 v52, 2, v42
  v_cmp_gt_u32 vcc, s71, v1
  s_mov_b64 exec, 15
  buffer_load_dword v52, v52, s[28:31], 0 offen
  s_mov_b64 exec, vcc
  s_waitcnt vmcnt(5)
  v_lshlrev_b32 v9, 4, v8
  v_sub_u32 v9, s44, v9
  v_med3_i32 v9, v9, 0, 16
  v_cmp_gt_u32 vcc, s45, v8
  v_lshl_or_b32 v48, v48, 15, v9
  v_bfrev_b32 v9, 1
  v_and_b32 v48, 0x7fffffff, v48
  v_cndmask_b32 v48, v9, v48, vcc
  v_add_u32 v8, 1, v8
  v_lshlrev_b32 v9, 4, v8
  v_sub_u32 v9, s44, v9
  v_med3_i32 v9, v9, 0, 16
  v_cmp_gt_u32 vcc, s45, v8
  v_lshl_or_b32 v49, v49, 15, v9
  v_bfrev_b32 v9, 1
  v_and_b32 v49, 0x7fffffff, v49
  v_cndmask_b32 v49, v9, v49, vcc
  v_add_u32 v8, 1, v8
  v_lshlrev_b32 v9, 4, v8
  v_sub_u32 v9, s44, v9
  v_med3_i32 v9, v9, 0, 16
  v_cmp_gt_u32 vcc, s45, v8
  v_lshl_or_b32 v50, v50, 15, v9
  v_bfrev_b32 v9, 1
  v_and_b32 v50, 0x7fffffff, v50
  v_cndmask_b32 v50, v9, v50, vcc
  v_add_u32 v8, 1, v8
  v_lshlrev_b32 v9, 4, v8
  v_sub_u32 v9, s44, v9
  v_med3_i32 v9, v9, 0, 16
  v_cmp_gt_u32 vcc, s45, v8
  v_lshl_or_b32 v51, v51, 15, v9
  v_bfrev_b32 v9, 1
  v_and_b32 v51, 0x7fffffff, v51
  v_cndmask_b32 v51, v9, v51, vcc
  ds_write_b128 v43, v[48:51]
  s_mov_b64 exec, -1
  s_mov_b64 s[64:65], s[14:15]
  s_mov_b32 s66, 8192
  s_mov_b32 s67, 0x20000
  s_mov_b32 s49, 0xffff0000
  s_mov_b64 s[60:61], s[16:17]
  s_mov_b32 s62, 256
  s_mov_b32 s63, 0x20000
  s_getreg_b32 s82, hwreg(HW_REG_XCC_ID)
  s_lshl_b32 s52, s40, 5
  v_mov_b32 v44, s52
  s_and_b32 s82, s82, 15
  s_add_u32 s82, s82, 1
  s_mov_b32 s77, 0
  s_cmp_eq_u32 s72, 0
  s_cbranch_scc0 L_nl
  v_mov_b32 v8, s82
  s_mov_b64 exec, 1
  buffer_store_dword v8, v44, s[60:63], 0 offen offset:4 sc1
  s_mov_b64 exec, -1
L_nl:
  s_waitcnt vmcnt(0)
  v_lshlrev_b32 v9, 4, v42
  v_sub_u32 v9, s44, v9
  v_med3_i32 v9, v9, 0, 16
  v_cmp_gt_u32 vcc, s45, v42
  v_lshl_or_b32 v52, v52, 15, v9
  v_bfrev_b32 v9, 1
  v_and_b32 v52, 0x7fffffff, v52
  v_cndmask_b32 v52, v9, v52, vcc
  s_lshl_b32 s68, s71, 4
  v_lshl_add_u32 v43, v1, 2, s68
  s_sub_i32 s68, s68, 48
  s_min_i32 s48, s68, 96
  s_mov_b32 s46, 0
L_s0:
  ds_read_b32 v8, v10
  s_waitcnt lgkmcnt(0)
  v_readfirstlane_b32 s52, v8
  s_cmp_ge_i32 s52, s48
  s_cbranch_scc1 L_s2
  s_sleep 4
  s_branch L_s0
L_s2:
  buffer_load_dwordx2 v[28:29], v44, s[60:63], 0 offen sc1
  s_waitcnt vmcnt(0)
  v_readfirstlane_b32 s53, v28
  v_readfirstlane_b32 s52, v29
  s_or_b32 s77, s77, s53
  s_cmp_lg_u32 s46, 0
  s_cbranch_scc1 L_s1
  s_mov_b32 s46, 1
  s_mov_b32 s48, s68
  s_cmp_eq_u32 s52, s82
  s_cbranch_scc1 L_s0
  s_mov_b32 s77, 32
  v_mov_b32 v8, 32
  s_mov_b64 exec, 1
  buffer_store_dword v8, v44, s[60:63], 0 offen sc1
  s_mov_b64 exec, -1
  s_branch L_s0
L_s1:
  s_and_b32 s77, s77, 32
  s_mov_b64 exec, 0xffff
  v_or_b32 v52, s77, v52
  ds_write_b32 v43, v52
  s_mov_b64 exec, -1
  s_mov_b32 s46, 0
  s_mov_b32 s76, 64
  v_bfe_u32 v8, v1, 2, 2
  v_lshlrev_b32 v8, 5, v8
  v_lshlrev_b32 v44, 2, v1
  s_waitcnt vmcnt(0)
L_gate:
  s_sleep 1
  ds_read_b32 v9, v10 offset:68
  ds_read_b128 v[64:67], v8 offset:1152
  ds_read_b128 v[68:71], v8 offset:1168
  s_waitcnt lgkmcnt(2)
  v_cmp_ne_u32 vcc, 16, v9
  s_cbranch_vccnz L_gate
  s_waitcnt lgkmcnt(0)
  v_max3_f32 v8, v64, v66, v68
  v_max_f32 v8, v8, v70
  v_sub_f32 v64, v64, v8
  v_sub_f32 v66, v66, v8
  v_sub_f32 v68, v68, v8
  v_sub_f32 v70, v70, v8
  v_exp_f32 v64, v64
  v_exp_f32 v66, v66
  v_exp_f32 v68, v68
  v_exp_f32 v70, v70
  v_xor_b32 v72, s70, v8
  v_mul_f32 v73, v64, v65
  v_fmac_f32 v73, v66, v67
  v_fmac_f32 v73, v68, v69
  v_fmac_f32 v73, v70, v71
  v_mov_b32 v74, s70
  v_mov_b32 v75, s70
  s_mov_b32 exec_lo, 0x1111
  s_mov_b32 exec_hi, 0
  s_cmp_lg_u32 s77, 0
  v_xor_b32 v73, s70, v73
  s_cbranch_scc1 L_ml1b
  buffer_store_dwordx4 v[72:75], v44, s[36:39], s58 offen
  s_branch L_ml3b
L_ml1b:
  buffer_store_dwordx4 v[72:75], v44, s[36:39], s58 offen sc1
L_ml3b:
  s_mov_b64 exec, -1
  s_branch L_m1
L_m0:
  s_bcnt1_i32_b64 s52, vcc
L_m2:
  s_sleep 1
  s_sub_i32 s52, s52, 16
  s_cmp_gt_i32 s52, 0
  s_cbranch_scc1 L_m2
  s_mov_b64 exec, vcc
L_m1:
  buffer_load_dword v16, v3, s[36:39], 0 offen sc1
  buffer_load_dword v17, v3, s[36:39], 0 offen offset:2048 sc1
  s_mov_b64 exec, -1
  s_add_u32 s46, s46, 1
  s_cmp_ge_u32 s46, s76
  s_cbranch_scc1 L_chk1
L_m3:
  s_waitcnt vmcnt(0)
  v_xor_b32 v36, v16, v20
  v_xor_b32 v37, v17, v21
  v_mov_b32_dpp v18, v16 quad_perm:[2,2,2,2] row_mask:0xf bank_mask:0xf
  v_min_u32 v36, v36, v37
  v_mov_b32_dpp v19, v17 quad_perm:[2,2,2,2] row_mask:0xf bank_mask:0xf
  v_cmp_eq_u32 vcc, 0, v36
  v_xor_b32_dpp v10, v16, v18 quad_perm:[0,0,0,0] row_mask:0xf bank_mask:0xf
  s_cbranch_vccnz L_m0
  buffer_load_dwordx2 v[32:33], v2, s[36:39], 0 offen sc1
  buffer_load_dwordx2 v[56:57], v60, s[36:39], 0 offen sc1
  v_xor_b32_dpp v14, v17, v19 quad_perm:[0,0,0,0] row_mask:0xf bank_mask:0xf
  v_xor_b32_dpp v11, v16, v18 quad_perm:[1,1,1,1] row_mask:0xf bank_mask:0xf
  v_max_f32 v12, v10, v14
  v_xor_b32_dpp v15, v17, v19 quad_perm:[1,1,1,1] row_mask:0xf bank_mask:0xf
  s_nop 0
  v_max_f32_dpp v12, v12, v12 row_ror:4 row_mask:0xf bank_mask:0xf
  s_nop 1
  v_max_f32_dpp v12, v12, v12 row_ror:8 row_mask:0xf bank_mask:0xf
  v_mov_b32 v9, v12
  s_nop 1
  v_permlane16_swap_b32 v12, v9
  v_max_f32 v12, v12, v9
  v_mov_b32 v9, v12
  s_nop 1
  v_permlane32_swap_b32 v12, v9
  v_max_f32 v12, v12, v9
  v_sub_f32 v10, v10, v12
  v_sub_f32 v14, v14, v12
  v_exp_f32 v10, v10
  v_exp_f32 v14, v14
  v_mul_f32 v11, v10, v11
  v_fmac_f32 v11, v14, v15
  s_nop 1
  v_add_f32_dpp v11, v11, v11 row_ror:4 row_mask:0xf bank_mask:0xf
  s_nop 1
  v_add_f32_dpp v11, v11, v11 row_ror:8 row_mask:0xf bank_mask:0xf
  v_mov_b32 v9, v11
  s_nop 1
  v_permlane16_swap_b32 v11, v9
  v_add_f32 v11, v11, v9
  v_mov_b32 v9, v11
  s_nop 1
  v_permlane32_swap_b32 v11, v9
  v_add_f32 v11, v11, v9
  v_rcp_f32 v11, v11
  s_nop 0
  v_mul_f32 v10, v10, v11
  v_mul_f32 v14, v14, v11
  s_branch L_o1
L_o0:
  s_mov_b64 exec, vcc
  buffer_load_dwordx2 v[32:33], v2, s[36:39], 0 offen sc1
  buffer_load_dwordx2 v[56:57], v60, s[36:39], 0 offen sc1
  s_mov_b64 exec, -1
  s_add_u32 s46, s46, 1
  s_cmp_ge_u32 s46, s76
  s_cbranch_scc1 L_chk2
L_o1:
  s_waitcnt vmcnt(0)
  v_xor_b32 v36, v32, v34
  v_xor_b32 v37, v33, v35
  v_xor_b32 v38, v56, v58
  v_xor_b32 v39, v57, v59
  v_min3_u32 v36, v36, v37, v38
  v_xor_b32 v8, v32, v18
  v_min_u32 v36, v36, v39
  v_xor_b32 v9, v33, v18
  v_cmp_eq_u32 vcc, 0, v36
  v_lshlrev_b32 v24, 16, v8
  v_and_b32 v25, s49, v8
  v_lshlrev_b32 v26, 16, v9
  v_and_b32 v27, s49, v9
  s_cbranch_vccnz L_o0
  v_xor_b32 v8, v56, v19
  v_xor_b32 v9, v57, v19
  v_mul_f32 v24, v10, v24
  v_mul_f32 v25, v10, v25
  v_mul_f32 v26, v10, v26
  v_mul_f32 v27, v10, v27
  v_lshlrev_b32 v36, 16, v8
  v_and_b32 v37, s49, v8
  v_lshlrev_b32 v38, 16, v9
  v_and_b32 v39, s49, v9
  v_fmac_f32 v24, v14, v36
  v_fmac_f32 v25, v14, v37
  v_fmac_f32 v26, v14, v38
  v_fmac_f32 v27, v14, v39
  v_add_f32_dpp v24, v24, v24 row_ror:4 row_mask:0xf bank_mask:0xf
  v_add_f32_dpp v25, v25, v25 row_ror:4 row_mask:0xf bank_mask:0xf
  v_add_f32_dpp v26, v26, v26 row_ror:4 row_mask:0xf bank_mask:0xf
  v_add_f32_dpp v27, v27, v27 row_ror:4 row_mask:0xf bank_mask:0xf
  v_add_f32_dpp v24, v24, v24 row_ror:8 row_mask:0xf bank_mask:0xf
  v_add_f32_dpp v25, v25, v25 row_ror:8 row_mask:0xf bank_mask:0xf
  v_add_f32_dpp v26, v26, v26 row_ror:8 row_mask:0xf bank_mask:0xf
  v_add_f32_dpp v27, v27, v27 row_ror:8 row_mask:0xf bank_mask:0xf
  v_permlane16_swap_b32 v24, v25
  s_mov_b32 vcc_lo, 0x000f000f
  v_permlane16_swap_b32 v26, v27
  v_add_f32 v24, v24, v25
  v_add_f32 v26, v26, v27
  s_mov_b32 vcc_hi, 0x000f000f
  s_nop 0
  v_permlane32_swap_b32 v24, v26
  v_add_f32 v24, v24, v26
  s_mov_b64 exec, vcc
  v_cvt_pk_bf16_f32 v24, v24, v24
  buffer_store_short v24, v7, s[64:67], 0 offen
L_end:
  s_endpgm
L_mask:
  v_mov_b32 v11, s54
  s_sub_i32 s52, s47, 0
  v_cmp_gt_i32 vcc, s52, v7
  s_nop 1
  v_cndmask_b32 v20, v11, v20, vcc
  s_sub_i32 s52, s47, 1
  v_cmp_gt_i32 vcc, s52, v7
  s_nop 1
  v_cndmask_b32 v21, v11, v21, vcc
  s_sub_i32 s52, s47, 2
  v_cmp_gt_i32 vcc, s52, v7
  s_nop 1
  v_cndmask_b32 v22, v11, v22, vcc
  s_sub_i32 s52, s47, 3
  v_cmp_gt_i32 vcc, s52, v7
  s_nop 1
  v_cndmask_b32 v23, v11, v23, vcc
  s_branch L_nomask
L_chk1:
  s_cmp_ge_u32 s46, 2048
  s_cbranch_scc1 L_fb
  s_load_dword s52, s[12:13], 0
  s_mov_b32 s76, 2048
  s_waitcnt lgkmcnt(0)
  s_sub_u32 s52, s52, 1
  s_cmp_lt_u32 s52, 8192
  s_cbranch_scc0 L_m3
  s_branch L_fb
L_chk2:
  s_cmp_ge_u32 s46, 2048
  s_cbranch_scc1 L_fb
  s_load_dword s52, s[12:13], 0
  s_mov_b32 s76, 2048
  s_waitcnt lgkmcnt(0)
  s_sub_u32 s52, s52, 1
  s_cmp_lt_u32 s52, 8192
  s_cbranch_scc0 L_o1
L_fb:
  s_load_dword s44, s[12:13], 0
  s_waitcnt vmcnt(0) lgkmcnt(0)
  s_min_i32 s52, s44, 65536
  s_cmp_le_i32 s44, 0
  s_cselect_b32 s52, 65536, s52
  s_add_u32 s52, s52, 15
  s_lshr_b32 s45, s52, 4
  s_min_i32 s44, s44, 65536
  s_max_i32 s44, s44, 0
  s_mov_b32 s68, 0
  s_mov_b32 s41, 0
L_fbfill:
  s_mov_b64 s[28:29], s[10:11]
  s_mov_b32 s30, 16384
  s_mov_b32 s31, 0x20000
  v_add_u32 v122, s68, v1
  v_lshlrev_b32 v123, 2, v122
  buffer_load_dword v123, v123, s[28:31], 0 offen
  s_lshl_b32 s55, s68, 2
  s_waitcnt vmcnt(0)
  v_lshlrev_b32 v11, 4, v122
  v_sub_u32 v11, s44, v11
  v_med3_i32 v11, v11, 0, 16
  v_cmp_gt_u32 vcc, s45, v122
  v_lshl_or_b32 v123, v123, 15, v11
  v_bfrev_b32 v11, 1
  v_and_b32 v123, 0x7fffffff, v123
  v_cndmask_b32 v123, v11, v123, vcc
  s_bitset1_b32 s69, 31
  v_lshlrev_b32 v122, 2, v1
  v_writelane_b32 v123, s69, 63
  v_mov_b32 v124, 1024
  v_mov_b32 v126, 4
  ds_write_b32 v122, v123
  ds_write_b32 v124, v126
  s_branch L_setup
L_fbnext:
  s_waitcnt vmcnt(0)
  s_add_u32 s68, s68, 63
  s_cmp_lt_u32 s68, s45
  s_cbranch_scc1 L_fbfill
  v_mov_b32 v11, v9
  s_nop 1
  v_permlane32_swap_b32 v9, v11
  v_add_f32 v9, v9, v11
  v_mov_b32 v11, v9
  s_nop 1
  v_permlane16_swap_b32 v9, v11
  v_add_f32 v9, v9, v11
  v_rcp_f32 v12, v9
  s_nop 1
  v_mov_b32_dpp v13, v12 row_newbcast:0 row_mask:0x1 bank_mask:0xf
  s_nop 1
  v_mov_b32_dpp v13, v12 row_newbcast:4 row_mask:0x2 bank_mask:0xf
  s_nop 1
  v_mov_b32_dpp v13, v12 row_newbcast:8 row_mask:0x4 bank_mask:0xf
  s_nop 1
  v_mov_b32_dpp v13, v12 row_newbcast:12 row_mask:0x8 bank_mask:0xf
  v_mul_f32 v56, v13, v56
  v_mul_f32 v60, v13, v60
  v_mul_f32 v64, v13, v64
  v_mul_f32 v68, v13, v68
  v_mul_f32 v72, v13, v72
  v_mul_f32 v76, v13, v76
  v_mul_f32 v80, v13, v80
  v_mul_f32 v84, v13, v84
  v_cvt_pk_bf16_f32 v24, v56, v60
  v_cvt_pk_bf16_f32 v25, v64, v68
  v_cvt_pk_bf16_f32 v26, v72, v76
  v_cvt_pk_bf16_f32 v27, v80, v84
  s_mov_b64 s[64:65], s[14:15]
  s_mov_b32 s66, 8192
  s_mov_b32 s67, 0x20000
  s_lshl_b32 s52, s72, 1
  s_lshl_b32 s53, s40, 10
  v_lshlrev_b32 v11, 4, v1
  s_lshl_b64 exec, 3, s52
  buffer_store_dwordx4 v[24:27], v11, s[64:67], s53 offen
  s_endpgm
.section .rodata,"a"
.p2align 6
.amdhsa_kernel standalone__paged_block_table_kv_pagedattention__decode_kernel
  .amdhsa_next_free_vgpr 172
  .amdhsa_next_free_sgpr 88
  .amdhsa_accum_offset 172
  .amdhsa_group_segment_fixed_size 0
  .amdhsa_kernarg_size 64
  .amdhsa_user_sgpr_count 2
  .amdhsa_user_sgpr_kernarg_segment_ptr 1
  .amdhsa_system_sgpr_workgroup_id_x 1
.end_amdhsa_kernel
```
